```python
import torch

def _softmax(x, axis=-1):
    return torch.softmax(x, dim=axis)
def _gelu(x):
    return torch.nn.functional.gelu(x, approximate="tanh")
def _silu(x):
    return torch.nn.functional.silu(x)
def _sigmoid(x):
    return torch.sigmoid(x)
def _layernorm(x, axis=-1, eps=1e-5):
    m = x.mean(dim=axis, keepdim=True)
    v = x.var(dim=axis, keepdim=True, unbiased=False)
    return (x - m) / torch.sqrt(v + eps)
def _scatter_add(tgt, idx, src, axis=0):
    return tgt.clone().index_add_(axis, idx, src)
def _segment_sum(src, seg, n):
    out = torch.zeros((n,) + src.shape[1:], dtype=src.dtype)
    return out.index_add_(0, seg, src)
def _pad(x, pw):
    flat = tuple(v for pair in reversed(pw) for v in pair)
    return torch.nn.functional.pad(x, flat)

kernel_name = 'standalone__w4a16_gemm_dequant__prompt'

def setup_inputs():

    _w = (lambda a: (lambda t: t.to(torch.bfloat16) if t.is_floating_point() else t)(torch.as_tensor(a)))
    B, S, D, F = 1, 2048, 1024, 3584
    G = 128 if 128 > 0 else D
    D = (D // G) * G
    ng = D // G
    qw = torch.randint(0, 16, (D, F)).to(torch.int32)
    return {
        "x": _w((lambda *s: torch.randn(*s, dtype=torch.bfloat16) * 0.05)(B, S, D)),
        "qw": _w(qw),
        "scales": _w(torch.abs((lambda *s: torch.randn(*s, dtype=torch.bfloat16) * 0.05)(ng, F)) + 0.01),
        "zeros": _w(torch.full((ng, F), 8.0, dtype=float)),
    }

def reference(x, qw, scales, zeros):
    B, S, D = x.shape
    ng, F = scales.shape
    G = D // ng
    s = (lambda x, n, axis: torch.repeat_interleave(x, n, dim=axis))(scales, G, axis=0)
    z = (lambda x, n, axis: torch.repeat_interleave(x, n, dim=axis))(zeros, G, axis=0)
    w = ((lambda x, dt: x.to(dt))(qw, x.dtype) - z) * s
    return x @ w
```

```asm
; @launch grid=(256,1,1) block=(512,1,1) lds=135168
.amdgcn_target "amdgcn-amd-amdhsa--gfx950"
.text
.globl standalone__w4a16_gemm_dequant__prompt_kernel
.p2align 8
.type standalone__w4a16_gemm_dequant__prompt_kernel,@function
standalone__w4a16_gemm_dequant__prompt_kernel:
    s_cmp_ge_u32 s2, 256
    s_cbranch_scc1 L_done
    s_memrealtime s[96:97]
    s_load_dwordx4 s[4:7], s[0:1], 0
    s_load_dwordx4 s[8:11], s[0:1], 16
    s_load_dwordx4 s[12:15], s[0:1], 32
    s_load_dwordx2 s[44:45], s[0:1], 48
    s_waitcnt lgkmcnt(0)
    s_mov_b32 s16, s4
    s_and_b32 s17, s5, 0xffff
    s_mov_b32 s18, 4194304
    s_mov_b32 s19, 0x20000
    s_mov_b32 s20, s6
    s_and_b32 s21, s7, 0xffff
    s_mov_b32 s22, 14680064
    s_mov_b32 s23, 0x20000
    s_mov_b32 s24, s8
    s_and_b32 s25, s9, 0xffff
    s_mov_b32 s26, 57344
    s_mov_b32 s27, 0x20000
    s_mov_b32 s28, s10
    s_and_b32 s29, s11, 0xffff
    s_mov_b32 s30, 57344
    s_mov_b32 s31, 0x20000
    s_mov_b32 s32, s12
    s_and_b32 s33, s13, 0xffff
    s_mov_b32 s34, 14680064
    s_mov_b32 s35, 0x20000
    s_mov_b32 s36, s14
    s_and_b32 s37, s15, 0xffff
    s_mov_b32 s38, 256
    s_mov_b32 s39, 0x20000
    s_mov_b32 s40, s44
    s_and_b32 s41, s45, 0xffff
    s_mov_b32 s42, 0x10000000
    s_mov_b32 s43, 0x20000
    s_getreg_b32 s99, hwreg(HW_REG_XCC_ID, 0, 4)
    s_lshl_b32 s99, s99, 28
    s_sub_u32 s96, s96, 300
    s_subb_u32 s97, s97, 0
    s_and_b32 s97, s97, 0x0fffffff
    s_or_b32 s97, s97, s99
    s_mov_b32 s23, 0x74fac
    s_and_b32 s46, s2, 7
    s_lshr_b32 s47, s2, 3
    s_and_b32 s50, s47, 15
    s_lshr_b32 s49, s47, 4
    s_lshl_b32 s51, s46, 1
    s_add_u32 s51, s51, s49
    s_mul_i32 s100, s46, 2
    s_add_u32 s100, s100, s50
    s_and_b32 s100, s100, 15
    v_lshrrev_b32 v1, 6, v0
    v_and_b32 v2, 63, v0
    v_readfirstlane_b32 s52, v1
    v_lshlrev_b32 v3, 4, v2
    v_mov_b32 v6, 0x7ff00000
    v_cmp_gt_u32 s[76:77], 56, v2
    v_lshlrev_b32 v4, 3, v2
    s_nop 0
    v_cndmask_b32 v7, v6, v3, s[76:77]
    v_cndmask_b32 v4, v6, v4, s[76:77]
    s_lshl_b32 s69, s100, 3
    s_add_u32 s69, s69, s52
    s_mul_i32 s53, s69, 114688
    s_mul_i32 s54, s51, 896
    s_add_u32 s53, s53, s54
    buffer_load_format_d16_xyzw v[16:17], v7, s[20:23], s53 offen nt
    s_add_u32 s53, s53, 14336
    buffer_load_format_d16_xyzw v[18:19], v7, s[20:23], s53 offen nt
    s_add_u32 s53, s53, 14336
    buffer_load_format_d16_xyzw v[20:21], v7, s[20:23], s53 offen nt
    s_add_u32 s53, s53, 14336
    buffer_load_format_d16_xyzw v[22:23], v7, s[20:23], s53 offen nt
    s_add_u32 s53, s53, 14336
    buffer_load_format_d16_xyzw v[24:25], v7, s[20:23], s53 offen nt
    s_add_u32 s53, s53, 14336
    buffer_load_format_d16_xyzw v[26:27], v7, s[20:23], s53 offen nt
    s_add_u32 s53, s53, 14336
    buffer_load_format_d16_xyzw v[28:29], v7, s[20:23], s53 offen nt
    s_add_u32 s53, s53, 14336
    buffer_load_format_d16_xyzw v[30:31], v7, s[20:23], s53 offen nt
    s_lshr_b32 s54, s69, 4
    s_mul_i32 s54, s54, 7168
    s_mul_i32 s55, s51, 448
    s_add_u32 s54, s54, s55
    buffer_load_dwordx2 v[8:9], v4, s[24:27], s54 offen
    buffer_load_dwordx2 v[10:11], v4, s[28:31], s54 offen
    s_mul_i32 s55, s52, 3584
    s_add_u32 s55, s55, 16384
    v_lshl_add_u32 v5, v2, 6, s55
    s_cmp_ge_u32 s52, 4
    s_cbranch_scc1 L_helper
    v_mov_b32 v128, 0
    v_mov_b32 v129, 0
    v_mov_b32 v130, 0
    v_mov_b32 v131, 0
    v_mov_b32 v132, 0
    v_mov_b32 v133, 0
    v_mov_b32 v134, 0
    v_mov_b32 v135, 0
    v_mov_b32 v136, 0
    v_mov_b32 v137, 0
    v_mov_b32 v138, 0
    v_mov_b32 v139, 0
    v_mov_b32 v140, 0
    v_mov_b32 v141, 0
    v_mov_b32 v142, 0
    v_mov_b32 v143, 0
    v_mov_b32 v144, 0
    v_mov_b32 v145, 0
    v_mov_b32 v146, 0
    v_mov_b32 v147, 0
    v_mov_b32 v148, 0
    v_mov_b32 v149, 0
    v_mov_b32 v150, 0
    v_mov_b32 v151, 0
    v_mov_b32 v152, 0
    v_mov_b32 v153, 0
    v_mov_b32 v154, 0
    v_mov_b32 v155, 0
    v_mov_b32 v156, 0
    v_mov_b32 v157, 0
    v_mov_b32 v158, 0
    v_mov_b32 v159, 0
    v_mov_b32 v160, 0
    v_mov_b32 v161, 0
    v_mov_b32 v162, 0
    v_mov_b32 v163, 0
    v_mov_b32 v164, 0
    v_mov_b32 v165, 0
    v_mov_b32 v166, 0
    v_mov_b32 v167, 0
    v_mov_b32 v168, 0
    v_mov_b32 v169, 0
    v_mov_b32 v170, 0
    v_mov_b32 v171, 0
    v_mov_b32 v172, 0
    v_mov_b32 v173, 0
    v_mov_b32 v174, 0
    v_mov_b32 v175, 0
    v_mov_b32 v176, 0
    v_mov_b32 v177, 0
    v_mov_b32 v178, 0
    v_mov_b32 v179, 0
    v_mov_b32 v180, 0
    v_mov_b32 v181, 0
    v_mov_b32 v182, 0
    v_mov_b32 v183, 0
    v_mov_b32 v184, 0
    v_mov_b32 v185, 0
    v_mov_b32 v186, 0
    v_mov_b32 v187, 0
    v_mov_b32 v188, 0
    v_mov_b32 v189, 0
    v_mov_b32 v190, 0
    v_mov_b32 v191, 0
    v_mov_b32 v192, 0
    v_mov_b32 v193, 0
    v_mov_b32 v194, 0
    v_mov_b32 v195, 0
    v_mov_b32 v196, 0
    v_mov_b32 v197, 0
    v_mov_b32 v198, 0
    v_mov_b32 v199, 0
    v_mov_b32 v200, 0
    v_mov_b32 v201, 0
    v_mov_b32 v202, 0
    v_mov_b32 v203, 0
    v_mov_b32 v204, 0
    v_mov_b32 v205, 0
    v_mov_b32 v206, 0
    v_mov_b32 v207, 0
    v_mov_b32 v208, 0
    v_mov_b32 v209, 0
    v_mov_b32 v210, 0
    v_mov_b32 v211, 0
    v_mov_b32 v212, 0
    v_mov_b32 v213, 0
    v_mov_b32 v214, 0
    v_mov_b32 v215, 0
    v_mov_b32 v216, 0
    v_mov_b32 v217, 0
    v_mov_b32 v218, 0
    v_mov_b32 v219, 0
    v_mov_b32 v220, 0
    v_mov_b32 v221, 0
    v_mov_b32 v222, 0
    v_mov_b32 v223, 0
    v_mov_b32 v224, 0
    v_mov_b32 v225, 0
    v_mov_b32 v226, 0
    v_mov_b32 v227, 0
    v_mov_b32 v228, 0
    v_mov_b32 v229, 0
    v_mov_b32 v230, 0
    v_mov_b32 v231, 0
    v_mov_b32 v232, 0
    v_mov_b32 v233, 0
    v_mov_b32 v234, 0
    v_mov_b32 v235, 0
    v_mov_b32 v236, 0
    v_mov_b32 v237, 0
    v_mov_b32 v238, 0
    v_mov_b32 v239, 0
    s_waitcnt vmcnt(0)
    s_call_b64 s[72:73], SUB_DEQ
    v_and_b32 v3, 15, v2
    v_lshrrev_b32 v4, 4, v2
    v_lshrrev_b32 v5, 1, v3
    v_xor_b32 v5, v5, v4
    v_lshlrev_b32 v5, 4, v5
    v_lshl_add_u32 v5, v3, 7, v5
    s_lshr_b32 s53, s52, 1
    s_and_b32 s54, s52, 1
    s_lshl_b32 s55, s53, 13
    v_add_u32 v5, s55, v5
    v_xor_b32 v6, 64, v5
    v_mul_u32_u24 v7, 3584, v4
    v_lshl_add_u32 v7, v3, 4, v7
    s_mul_i32 s55, s54, 1792
    s_add_u32 s55, s55, 16384
    v_add_u32 v7, s55, v7
    v_mov_b32 v8, v5
    v_mov_b32 v9, v6
    v_mov_b32 v10, v7
    s_mov_b32 s60, 0
    s_mov_b32 s59, 0
    s_waitcnt lgkmcnt(0)
    s_barrier
    v_lshrrev_b32 v44, 3, v2
    v_and_b32 v45, 7, v2
    v_lshrrev_b32 v46, 1, v44
    v_xor_b32 v45, v45, v46
    s_lshl_b32 s55, s50, 7
    s_lshl_b32 s56, s52, 5
    s_add_u32 s55, s55, s56
    v_add_u32 v44, s55, v44
    v_lshlrev_b32 v44, 11, v44
    v_lshl_add_u32 v14, v45, 4, v44
    v_xor_b32 v15, 64, v14
    s_lshl_b32 s58, s52, 12
    s_lshl_b32 s56, s100, 7
    s_mov_b32 s61, 0
    s_barrier
    s_call_b64 s[72:73], SUB_X
    s_call_b64 s[72:73], SUB_X
    s_call_b64 s[72:73], SUB_X
    s_waitcnt vmcnt(8)
    s_barrier
    ds_read_b128 v[56:59], v10 offset:0
    ds_read_b128 v[40:43], v8 offset:0
    ds_read_b128 v[44:47], v8 offset:2048
    ds_read_b128 v[48:51], v8 offset:4096
    ds_read_b128 v[52:55], v8 offset:6144
    ds_read_b128 v[60:63], v10 offset:256
    ds_read_b128 v[64:67], v10 offset:512
    ds_read_b128 v[68:71], v10 offset:768
    ds_read_b128 v[72:75], v10 offset:1024
    ds_read_b128 v[76:79], v10 offset:1280
    ds_read_b128 v[80:83], v10 offset:1536
    s_mov_b32 s57, 7168
    s_movk_i32 s55, 464
    v_and_b32 v31, 255, v0
    v_add_u32 v32, 0, v31
    v_mul_u32_u24 v33, 9363, v32
    v_lshrrev_b32 v33, 18, v33
    v_mul_u32_u24 v34, 28, v33
    v_sub_u32 v34, v32, v34
    v_lshlrev_b32 v34, 4, v34
    v_and_b32 v35, 32, v33
    v_add_u32 v33, v33, v35
    v_add_u32 v33, 32, v33
    v_mad_u32_u24 v16, v33, s55, v34
    v_mad_u32_u24 v24, v33, s57, v34
    v_add_u32 v32, 256, v31
    v_mul_u32_u24 v33, 9363, v32
    v_lshrrev_b32 v33, 18, v33
    v_mul_u32_u24 v34, 28, v33
    v_sub_u32 v34, v32, v34
    v_lshlrev_b32 v34, 4, v34
    v_and_b32 v35, 32, v33
    v_add_u32 v33, v33, v35
    v_add_u32 v33, 32, v33
    v_mad_u32_u24 v17, v33, s55, v34
    v_mad_u32_u24 v25, v33, s57, v34
    v_add_u32 v32, 512, v31
    v_mul_u32_u24 v33, 9363, v32
    v_lshrrev_b32 v33, 18, v33
    v_mul_u32_u24 v34, 28, v33
    v_sub_u32 v34, v32, v34
    v_lshlrev_b32 v34, 4, v34
    v_and_b32 v35, 32, v33
    v_add_u32 v33, v33, v35
    v_add_u32 v33, 32, v33
    v_mad_u32_u24 v18, v33, s55, v34
    v_mad_u32_u24 v26, v33, s57, v34
    v_add_u32 v32, 768, v31
    v_mul_u32_u24 v33, 9363, v32
    v_lshrrev_b32 v33, 18, v33
    v_mul_u32_u24 v34, 28, v33
    v_sub_u32 v34, v32, v34
    v_lshlrev_b32 v34, 4, v34
    v_and_b32 v35, 32, v33
    v_add_u32 v33, v33, v35
    v_add_u32 v33, 32, v33
    v_mad_u32_u24 v19, v33, s55, v34
    v_mad_u32_u24 v27, v33, s57, v34
    v_add_u32 v32, 1024, v31
    v_mul_u32_u24 v33, 9363, v32
    v_lshrrev_b32 v33, 18, v33
    v_mul_u32_u24 v34, 28, v33
    v_sub_u32 v34, v32, v34
    v_lshlrev_b32 v34, 4, v34
    v_and_b32 v35, 32, v33
    v_add_u32 v33, v33, v35
    v_add_u32 v33, 32, v33
    v_mad_u32_u24 v20, v33, s55, v34
    v_mad_u32_u24 v28, v33, s57, v34
    v_add_u32 v32, 1280, v31
    v_mul_u32_u24 v33, 9363, v32
    v_lshrrev_b32 v33, 18, v33
    v_mul_u32_u24 v34, 28, v33
    v_sub_u32 v34, v32, v34
    v_lshlrev_b32 v34, 4, v34
    v_and_b32 v35, 32, v33
    v_add_u32 v33, v33, v35
    v_add_u32 v33, 32, v33
    v_mad_u32_u24 v21, v33, s55, v34
    v_mad_u32_u24 v29, v33, s57, v34
    v_add_u32 v32, 1536, v31
    v_mul_u32_u24 v33, 9363, v32
    v_lshrrev_b32 v33, 18, v33
    v_mul_u32_u24 v34, 28, v33
    v_sub_u32 v34, v32, v34
    v_lshlrev_b32 v34, 4, v34
    v_and_b32 v35, 32, v33
    v_add_u32 v33, v33, v35
    v_add_u32 v33, 32, v33
    v_mad_u32_u24 v22, v33, s55, v34
    v_mad_u32_u24 v30, v33, s57, v34
    s_lshl_b32 s55, s53, 6
    v_add_u32 v11, s55, v3
    v_mul_u32_u24 v11, 464, v11
    v_lshl_add_u32 v11, v4, 3, v11
    s_mul_i32 s55, s54, 224
    v_add_u32 v11, s55, v11
    s_waitcnt lgkmcnt(0)
    v_mfma_f32_16x16x32_bf16 v[128:131], v[56:59], v[40:43], v[128:131]
    v_mfma_f32_16x16x32_bf16 v[156:159], v[56:59], v[44:47], v[156:159]
    ds_read_b128 v[100:103], v10 offset:14336
    v_mfma_f32_16x16x32_bf16 v[184:187], v[56:59], v[48:51], v[184:187]
    v_mfma_f32_16x16x32_bf16 v[212:215], v[56:59], v[52:55], v[212:215]
    ds_read_b128 v[84:87], v9 offset:0
    v_mfma_f32_16x16x32_bf16 v[132:135], v[60:63], v[40:43], v[132:135]
    v_mfma_f32_16x16x32_bf16 v[160:163], v[60:63], v[44:47], v[160:163]
    ds_read_b128 v[88:91], v9 offset:2048
    v_mfma_f32_16x16x32_bf16 v[188:191], v[60:63], v[48:51], v[188:191]
    v_mfma_f32_16x16x32_bf16 v[216:219], v[60:63], v[52:55], v[216:219]
    ds_read_b128 v[92:95], v9 offset:4096
    v_mfma_f32_16x16x32_bf16 v[136:139], v[64:67], v[40:43], v[136:139]
    v_mfma_f32_16x16x32_bf16 v[164:167], v[64:67], v[44:47], v[164:167]
    ds_read_b128 v[96:99], v9 offset:6144
    v_mfma_f32_16x16x32_bf16 v[192:195], v[64:67], v[48:51], v[192:195]
    v_mfma_f32_16x16x32_bf16 v[220:223], v[64:67], v[52:55], v[220:223]
    ds_read_b128 v[104:107], v10 offset:14592
    v_mfma_f32_16x16x32_bf16 v[140:143], v[68:71], v[40:43], v[140:143]
    v_mfma_f32_16x16x32_bf16 v[168:171], v[68:71], v[44:47], v[168:171]
    ds_read_b128 v[108:111], v10 offset:14848
    v_mfma_f32_16x16x32_bf16 v[196:199], v[68:71], v[48:51], v[196:199]
    v_mfma_f32_16x16x32_bf16 v[224:227], v[68:71], v[52:55], v[224:227]
    ds_read_b128 v[112:115], v10 offset:15104
    v_mfma_f32_16x16x32_bf16 v[144:147], v[72:75], v[40:43], v[144:147]
    v_mfma_f32_16x16x32_bf16 v[172:175], v[72:75], v[44:47], v[172:175]
    ds_read_b128 v[116:119], v10 offset:15360
    v_mfma_f32_16x16x32_bf16 v[200:203], v[72:75], v[48:51], v[200:203]
    v_mfma_f32_16x16x32_bf16 v[228:231], v[72:75], v[52:55], v[228:231]
    ds_read_b128 v[120:123], v10 offset:15616
    v_mfma_f32_16x16x32_bf16 v[148:151], v[76:79], v[40:43], v[148:151]
    v_mfma_f32_16x16x32_bf16 v[176:179], v[76:79], v[44:47], v[176:179]
    ds_read_b128 v[124:127], v10 offset:15872
    v_mfma_f32_16x16x32_bf16 v[204:207], v[76:79], v[48:51], v[204:207]
    v_mfma_f32_16x16x32_bf16 v[232:235], v[76:79], v[52:55], v[232:235]
    v_mfma_f32_16x16x32_bf16 v[152:155], v[80:83], v[40:43], v[152:155]
    v_mfma_f32_16x16x32_bf16 v[180:183], v[80:83], v[44:47], v[180:183]
    v_mfma_f32_16x16x32_bf16 v[208:211], v[80:83], v[48:51], v[208:211]
    v_mfma_f32_16x16x32_bf16 v[236:239], v[80:83], v[52:55], v[236:239]
    s_waitcnt lgkmcnt(0)
    v_mfma_f32_16x16x32_bf16 v[128:131], v[100:103], v[84:87], v[128:131]
    v_mfma_f32_16x16x32_bf16 v[156:159], v[100:103], v[88:91], v[156:159]
    v_mfma_f32_16x16x32_bf16 v[184:187], v[100:103], v[92:95], v[184:187]
    v_mfma_f32_16x16x32_bf16 v[212:215], v[100:103], v[96:99], v[212:215]
    v_mfma_f32_16x16x32_bf16 v[132:135], v[104:107], v[84:87], v[132:135]
    v_mfma_f32_16x16x32_bf16 v[160:163], v[104:107], v[88:91], v[160:163]
    v_mfma_f32_16x16x32_bf16 v[188:191], v[104:107], v[92:95], v[188:191]
    v_mfma_f32_16x16x32_bf16 v[216:219], v[104:107], v[96:99], v[216:219]
    v_mfma_f32_16x16x32_bf16 v[136:139], v[108:111], v[84:87], v[136:139]
    v_mfma_f32_16x16x32_bf16 v[164:167], v[108:111], v[88:91], v[164:167]
    v_mfma_f32_16x16x32_bf16 v[192:195], v[108:111], v[92:95], v[192:195]
    v_mfma_f32_16x16x32_bf16 v[220:223], v[108:111], v[96:99], v[220:223]
    v_mfma_f32_16x16x32_bf16 v[140:143], v[112:115], v[84:87], v[140:143]
    v_mfma_f32_16x16x32_bf16 v[168:171], v[112:115], v[88:91], v[168:171]
    v_mfma_f32_16x16x32_bf16 v[196:199], v[112:115], v[92:95], v[196:199]
    v_mfma_f32_16x16x32_bf16 v[224:227], v[112:115], v[96:99], v[224:227]
    v_mfma_f32_16x16x32_bf16 v[144:147], v[116:119], v[84:87], v[144:147]
    v_mfma_f32_16x16x32_bf16 v[172:175], v[116:119], v[88:91], v[172:175]
    v_mfma_f32_16x16x32_bf16 v[200:203], v[116:119], v[92:95], v[200:203]
    v_mfma_f32_16x16x32_bf16 v[228:231], v[116:119], v[96:99], v[228:231]
    v_mfma_f32_16x16x32_bf16 v[148:151], v[120:123], v[84:87], v[148:151]
    v_mfma_f32_16x16x32_bf16 v[176:179], v[120:123], v[88:91], v[176:179]
    v_mfma_f32_16x16x32_bf16 v[204:207], v[120:123], v[92:95], v[204:207]
    v_mfma_f32_16x16x32_bf16 v[232:235], v[120:123], v[96:99], v[232:235]
    v_mfma_f32_16x16x32_bf16 v[152:155], v[124:127], v[84:87], v[152:155]
    v_mfma_f32_16x16x32_bf16 v[180:183], v[124:127], v[88:91], v[180:183]
    v_mfma_f32_16x16x32_bf16 v[208:211], v[124:127], v[92:95], v[208:211]
    v_mfma_f32_16x16x32_bf16 v[236:239], v[124:127], v[96:99], v[236:239]
    s_mov_b32 s60, 45056
    s_mov_b32 s59, 1
    v_add_u32 v8, s60, v5
    v_add_u32 v9, s60, v6
    v_add_u32 v10, s60, v7
    s_waitcnt vmcnt(0)
    s_barrier
    ds_read_b128 v[56:59], v10 offset:0
    ds_read_b128 v[40:43], v8 offset:0
    ds_read_b128 v[44:47], v8 offset:2048
    ds_read_b128 v[48:51], v8 offset:4096
    ds_read_b128 v[52:55], v8 offset:6144
    ds_read_b128 v[60:63], v10 offset:256
    ds_read_b128 v[64:67], v10 offset:512
    ds_read_b128 v[68:71], v10 offset:768
    ds_read_b128 v[72:75], v10 offset:1024
    ds_read_b128 v[76:79], v10 offset:1280
    ds_read_b128 v[80:83], v10 offset:1536
    s_branch L_c_p2
L_c_loop:
    s_waitcnt lgkmcnt(0)
    v_mfma_f32_16x16x32_bf16 v[128:131], v[100:103], v[84:87], v[128:131]
    v_mfma_f32_16x16x32_bf16 v[156:159], v[100:103], v[88:91], v[156:159]
    ds_read_b128 v[56:59], v10 offset:0
    v_mfma_f32_16x16x32_bf16 v[184:187], v[100:103], v[92:95], v[184:187]
    v_mfma_f32_16x16x32_bf16 v[212:215], v[100:103], v[96:99], v[212:215]
    ds_read_b128 v[40:43], v8 offset:0
    v_mfma_f32_16x16x32_bf16 v[132:135], v[104:107], v[84:87], v[132:135]
    v_mfma_f32_16x16x32_bf16 v[160:163], v[104:107], v[88:91], v[160:163]
    ds_read_b128 v[44:47], v8 offset:2048
    v_mfma_f32_16x16x32_bf16 v[188:191], v[104:107], v[92:95], v[188:191]
    v_mfma_f32_16x16x32_bf16 v[216:219], v[104:107], v[96:99], v[216:219]
    ds_read_b128 v[48:51], v8 offset:4096
    v_mfma_f32_16x16x32_bf16 v[136:139], v[108:111], v[84:87], v[136:139]
    v_mfma_f32_16x16x32_bf16 v[164:167], v[108:111], v[88:91], v[164:167]
    ds_read_b128 v[52:55], v8 offset:6144
    v_mfma_f32_16x16x32_bf16 v[192:195], v[108:111], v[92:95], v[192:195]
    v_mfma_f32_16x16x32_bf16 v[220:223], v[108:111], v[96:99], v[220:223]
    ds_read_b128 v[60:63], v10 offset:256
    v_mfma_f32_16x16x32_bf16 v[140:143], v[112:115], v[84:87], v[140:143]
    v_mfma_f32_16x16x32_bf16 v[168:171], v[112:115], v[88:91], v[168:171]
    ds_read_b128 v[64:67], v10 offset:512
    v_mfma_f32_16x16x32_bf16 v[196:199], v[112:115], v[92:95], v[196:199]
    v_mfma_f32_16x16x32_bf16 v[224:227], v[112:115], v[96:99], v[224:227]
    ds_read_b128 v[68:71], v10 offset:768
    v_mfma_f32_16x16x32_bf16 v[144:147], v[116:119], v[84:87], v[144:147]
    v_mfma_f32_16x16x32_bf16 v[172:175], v[116:119], v[88:91], v[172:175]
    ds_read_b128 v[72:75], v10 offset:1024
    v_mfma_f32_16x16x32_bf16 v[200:203], v[116:119], v[92:95], v[200:203]
    v_mfma_f32_16x16x32_bf16 v[228:231], v[116:119], v[96:99], v[228:231]
    ds_read_b128 v[76:79], v10 offset:1280
    v_mfma_f32_16x16x32_bf16 v[148:151], v[120:123], v[84:87], v[148:151]
    v_mfma_f32_16x16x32_bf16 v[176:179], v[120:123], v[88:91], v[176:179]
    ds_read_b128 v[80:83], v10 offset:1536
    v_mfma_f32_16x16x32_bf16 v[204:207], v[120:123], v[92:95], v[204:207]
    v_mfma_f32_16x16x32_bf16 v[232:235], v[120:123], v[96:99], v[232:235]
    v_mfma_f32_16x16x32_bf16 v[152:155], v[124:127], v[84:87], v[152:155]
    v_mfma_f32_16x16x32_bf16 v[180:183], v[124:127], v[88:91], v[180:183]
    v_mfma_f32_16x16x32_bf16 v[208:211], v[124:127], v[92:95], v[208:211]
    v_mfma_f32_16x16x32_bf16 v[236:239], v[124:127], v[96:99], v[236:239]
L_c_p2:
    s_waitcnt lgkmcnt(0)
    v_mfma_f32_16x16x32_bf16 v[128:131], v[56:59], v[40:43], v[128:131]
    ds_read_b128 v[100:103], v10 offset:14336
    v_mfma_f32_16x16x32_bf16 v[156:159], v[56:59], v[44:47], v[156:159]
    ds_read_b128 v[84:87], v9 offset:0
    v_mfma_f32_16x16x32_bf16 v[184:187], v[56:59], v[48:51], v[184:187]
    ds_read_b128 v[88:91], v9 offset:2048
    v_mfma_f32_16x16x32_bf16 v[212:215], v[56:59], v[52:55], v[212:215]
    ds_read_b128 v[92:95], v9 offset:4096
    v_mfma_f32_16x16x32_bf16 v[132:135], v[60:63], v[40:43], v[132:135]
    ds_read_b128 v[96:99], v9 offset:6144
    v_mfma_f32_16x16x32_bf16 v[160:163], v[60:63], v[44:47], v[160:163]
    ds_read_b128 v[104:107], v10 offset:14592
    v_mfma_f32_16x16x32_bf16 v[188:191], v[60:63], v[48:51], v[188:191]
    ds_read_b128 v[108:111], v10 offset:14848
    v_mfma_f32_16x16x32_bf16 v[216:219], v[60:63], v[52:55], v[216:219]
    ds_read_b128 v[112:115], v10 offset:15104
    v_mfma_f32_16x16x32_bf16 v[136:139], v[64:67], v[40:43], v[136:139]
    ds_read_b128 v[116:119], v10 offset:15360
    v_mfma_f32_16x16x32_bf16 v[164:167], v[64:67], v[44:47], v[164:167]
    ds_read_b128 v[120:123], v10 offset:15616
    v_mfma_f32_16x16x32_bf16 v[192:195], v[64:67], v[48:51], v[192:195]
    ds_read_b128 v[124:127], v10 offset:15872
    v_mfma_f32_16x16x32_bf16 v[220:223], v[64:67], v[52:55], v[220:223]
    v_mfma_f32_16x16x32_bf16 v[140:143], v[68:71], v[40:43], v[140:143]
    v_mfma_f32_16x16x32_bf16 v[168:171], v[68:71], v[44:47], v[168:171]
    v_mfma_f32_16x16x32_bf16 v[196:199], v[68:71], v[48:51], v[196:199]
    v_mfma_f32_16x16x32_bf16 v[224:227], v[68:71], v[52:55], v[224:227]
    s_add_u32 s60, s60, 45056
    s_cmp_eq_u32 s60, 135168
    s_cselect_b32 s60, 0, s60
    s_add_u32 s59, s59, 1
    s_waitcnt lgkmcnt(0)
    s_barrier
    v_add_u32 v8, s60, v5
    v_add_u32 v9, s60, v6
    v_add_u32 v10, s60, v7
    v_mfma_f32_16x16x32_bf16 v[144:147], v[72:75], v[40:43], v[144:147]
    v_mfma_f32_16x16x32_bf16 v[172:175], v[72:75], v[44:47], v[172:175]
    v_mfma_f32_16x16x32_bf16 v[200:203], v[72:75], v[48:51], v[200:203]
    v_mfma_f32_16x16x32_bf16 v[228:231], v[72:75], v[52:55], v[228:231]
    v_mfma_f32_16x16x32_bf16 v[148:151], v[76:79], v[40:43], v[148:151]
    v_mfma_f32_16x16x32_bf16 v[176:179], v[76:79], v[44:47], v[176:179]
    v_mfma_f32_16x16x32_bf16 v[204:207], v[76:79], v[48:51], v[204:207]
    v_mfma_f32_16x16x32_bf16 v[232:235], v[76:79], v[52:55], v[232:235]
    v_mfma_f32_16x16x32_bf16 v[152:155], v[80:83], v[40:43], v[152:155]
    v_mfma_f32_16x16x32_bf16 v[180:183], v[80:83], v[44:47], v[180:183]
    v_mfma_f32_16x16x32_bf16 v[208:211], v[80:83], v[48:51], v[208:211]
    v_mfma_f32_16x16x32_bf16 v[236:239], v[80:83], v[52:55], v[236:239]
    s_cmp_lt_u32 s59, 16
    s_cbranch_scc1 L_c_loop
    v_mfma_f32_16x16x32_bf16 v[128:131], v[100:103], v[84:87], v[128:131]
    v_mfma_f32_16x16x32_bf16 v[156:159], v[100:103], v[88:91], v[156:159]
    v_mfma_f32_16x16x32_bf16 v[132:135], v[104:107], v[84:87], v[132:135]
    v_mfma_f32_16x16x32_bf16 v[160:163], v[104:107], v[88:91], v[160:163]
    v_mfma_f32_16x16x32_bf16 v[136:139], v[108:111], v[84:87], v[136:139]
    v_mfma_f32_16x16x32_bf16 v[164:167], v[108:111], v[88:91], v[164:167]
    v_mfma_f32_16x16x32_bf16 v[140:143], v[112:115], v[84:87], v[140:143]
    v_mfma_f32_16x16x32_bf16 v[168:171], v[112:115], v[88:91], v[168:171]
    v_mfma_f32_16x16x32_bf16 v[144:147], v[116:119], v[84:87], v[144:147]
    v_mfma_f32_16x16x32_bf16 v[172:175], v[116:119], v[88:91], v[172:175]
    v_mfma_f32_16x16x32_bf16 v[148:151], v[120:123], v[84:87], v[148:151]
    v_mfma_f32_16x16x32_bf16 v[176:179], v[120:123], v[88:91], v[176:179]
    v_mfma_f32_16x16x32_bf16 v[152:155], v[124:127], v[84:87], v[152:155]
    v_mfma_f32_16x16x32_bf16 v[180:183], v[124:127], v[88:91], v[180:183]
    v_mfma_f32_16x16x32_bf16 v[184:187], v[100:103], v[92:95], v[184:187]
    v_cvt_pk_bf16_f32 v32, v128, v129
    v_cvt_pk_bf16_f32 v33, v130, v131
    ds_write_b64 v11, v[32:33] offset:0
    v_mfma_f32_16x16x32_bf16 v[212:215], v[100:103], v[96:99], v[212:215]
    v_cvt_pk_bf16_f32 v34, v156, v157
    v_cvt_pk_bf16_f32 v35, v158, v159
    ds_write_b64 v11, v[34:35] offset:7424
    v_mfma_f32_16x16x32_bf16 v[188:191], v[104:107], v[92:95], v[188:191]
    v_cvt_pk_bf16_f32 v36, v132, v133
    v_cvt_pk_bf16_f32 v37, v134, v135
    ds_write_b64 v11, v[36:37] offset:32
    v_mfma_f32_16x16x32_bf16 v[216:219], v[104:107], v[96:99], v[216:219]
    v_cvt_pk_bf16_f32 v38, v160, v161
    v_cvt_pk_bf16_f32 v39, v162, v163
    ds_write_b64 v11, v[38:39] offset:7456
    v_mfma_f32_16x16x32_bf16 v[192:195], v[108:111], v[92:95], v[192:195]
    v_cvt_pk_bf16_f32 v32, v136, v137
    v_cvt_pk_bf16_f32 v33, v138, v139
    ds_write_b64 v11, v[32:33] offset:64
    v_mfma_f32_16x16x32_bf16 v[220:223], v[108:111], v[96:99], v[220:223]
    v_cvt_pk_bf16_f32 v34, v164, v165
    v_cvt_pk_bf16_f32 v35, v166, v167
    ds_write_b64 v11, v[34:35] offset:7488
    v_mfma_f32_16x16x32_bf16 v[196:199], v[112:115], v[92:95], v[196:199]
    v_cvt_pk_bf16_f32 v36, v140, v141
    v_cvt_pk_bf16_f32 v37, v142, v143
    ds_write_b64 v11, v[36:37] offset:96
    v_mfma_f32_16x16x32_bf16 v[224:227], v[112:115], v[96:99], v[224:227]
    v_cvt_pk_bf16_f32 v38, v168, v169
    v_cvt_pk_bf16_f32 v39, v170, v171
    ds_write_b64 v11, v[38:39] offset:7520
    v_mfma_f32_16x16x32_bf16 v[200:203], v[116:119], v[92:95], v[200:203]
    v_cvt_pk_bf16_f32 v32, v144, v145
    v_cvt_pk_bf16_f32 v33, v146, v147
    ds_write_b64 v11, v[32:33] offset:128
    v_mfma_f32_16x16x32_bf16 v[228:231], v[116:119], v[96:99], v[228:231]
    v_cvt_pk_bf16_f32 v34, v172, v173
    v_cvt_pk_bf16_f32 v35, v174, v175
    ds_write_b64 v11, v[34:35] offset:7552
    v_mfma_f32_16x16x32_bf16 v[204:207], v[120:123], v[92:95], v[204:207]
    v_cvt_pk_bf16_f32 v36, v148, v149
    v_cvt_pk_bf16_f32 v37, v150, v151
    ds_write_b64 v11, v[36:37] offset:160
    v_mfma_f32_16x16x32_bf16 v[232:235], v[120:123], v[96:99], v[232:235]
    v_cvt_pk_bf16_f32 v38, v176, v177
    v_cvt_pk_bf16_f32 v39, v178, v179
    ds_write_b64 v11, v[38:39] offset:7584
    v_mfma_f32_16x16x32_bf16 v[208:211], v[124:127], v[92:95], v[208:211]
    v_cvt_pk_bf16_f32 v32, v152, v153
    v_cvt_pk_bf16_f32 v33, v154, v155
    ds_write_b64 v11, v[32:33] offset:192
    v_mfma_f32_16x16x32_bf16 v[236:239], v[124:127], v[96:99], v[236:239]
    v_cvt_pk_bf16_f32 v34, v180, v181
    v_cvt_pk_bf16_f32 v35, v182, v183
    ds_write_b64 v11, v[34:35] offset:7616
    s_waitcnt lgkmcnt(0)
    s_barrier
    v_cvt_pk_bf16_f32 v32, v184, v185
    v_cvt_pk_bf16_f32 v33, v186, v187
    ds_write_b64 v11, v[32:33] offset:14848
    v_cvt_pk_bf16_f32 v34, v212, v213
    v_cvt_pk_bf16_f32 v35, v214, v215
    ds_write_b64 v11, v[34:35] offset:22272
    v_cvt_pk_bf16_f32 v36, v188, v189
    v_cvt_pk_bf16_f32 v37, v190, v191
    ds_write_b64 v11, v[36:37] offset:14880
    v_cvt_pk_bf16_f32 v38, v216, v217
    v_cvt_pk_bf16_f32 v39, v218, v219
    ds_write_b64 v11, v[38:39] offset:22304
    v_cvt_pk_bf16_f32 v32, v192, v193
    v_cvt_pk_bf16_f32 v33, v194, v195
    ds_write_b64 v11, v[32:33] offset:14912
    v_cvt_pk_bf16_f32 v34, v220, v221
    v_cvt_pk_bf16_f32 v35, v222, v223
    ds_write_b64 v11, v[34:35] offset:22336
    v_cvt_pk_bf16_f32 v36, v196, v197
    v_cvt_pk_bf16_f32 v37, v198, v199
    ds_write_b64 v11, v[36:37] offset:14944
    v_cvt_pk_bf16_f32 v38, v224, v225
    v_cvt_pk_bf16_f32 v39, v226, v227
    ds_write_b64 v11, v[38:39] offset:22368
    v_cvt_pk_bf16_f32 v32, v200, v201
    v_cvt_pk_bf16_f32 v33, v202, v203
    ds_write_b64 v11, v[32:33] offset:14976
    v_cvt_pk_bf16_f32 v34, v228, v229
    v_cvt_pk_bf16_f32 v35, v230, v231
    ds_write_b64 v11, v[34:35] offset:22400
    v_cvt_pk_bf16_f32 v36, v204, v205
    v_cvt_pk_bf16_f32 v37, v206, v207
    ds_write_b64 v11, v[36:37] offset:15008
    v_cvt_pk_bf16_f32 v38, v232, v233
    v_cvt_pk_bf16_f32 v39, v234, v235
    ds_write_b64 v11, v[38:39] offset:22432
    v_cvt_pk_bf16_f32 v32, v208, v209
    v_cvt_pk_bf16_f32 v33, v210, v211
    ds_write_b64 v11, v[32:33] offset:15040
    v_cvt_pk_bf16_f32 v34, v236, v237
    v_cvt_pk_bf16_f32 v35, v238, v239
    ds_write_b64 v11, v[34:35] offset:22464
    s_waitcnt lgkmcnt(0)
    s_barrier
L_store:
    s_lshl_b32 s55, s50, 7
    s_mul_i32 s55, s55, 7168
    s_mul_i32 s56, s51, 448
    s_add_u32 s55, s55, s56
    ds_read_b128 v[40:43], v16
    ds_read_b128 v[44:47], v17
    ds_read_b128 v[48:51], v18
    ds_read_b128 v[52:55], v19
    ds_read_b128 v[56:59], v20
    ds_read_b128 v[60:63], v21
    ds_read_b128 v[64:67], v22
    s_waitcnt lgkmcnt(6)
    buffer_store_dwordx4 v[40:43], v24, s[32:35], s55 offen nt
    s_waitcnt lgkmcnt(5)
    buffer_store_dwordx4 v[44:47], v25, s[32:35], s55 offen nt
    s_waitcnt lgkmcnt(4)
    buffer_store_dwordx4 v[48:51], v26, s[32:35], s55 offen nt
    s_waitcnt lgkmcnt(3)
    buffer_store_dwordx4 v[52:55], v27, s[32:35], s55 offen nt
    s_waitcnt lgkmcnt(2)
    buffer_store_dwordx4 v[56:59], v28, s[32:35], s55 offen nt
    s_waitcnt lgkmcnt(1)
    buffer_store_dwordx4 v[60:63], v29, s[32:35], s55 offen nt
    s_waitcnt lgkmcnt(0)
    buffer_store_dwordx4 v[64:67], v30, s[32:35], s55 offen nt
    s_cmp_lt_u32 s52, 4
    s_cbranch_scc1 L_fin
    s_barrier
L_fin:
    s_endpgm
SUB_DEQ:
    v_lshlrev_b32 v48, 16, v8
    v_and_b32 v49, 0xffff0000, v8
    v_lshlrev_b32 v50, 16, v9
    v_and_b32 v51, 0xffff0000, v9
    v_lshlrev_b32 v52, 16, v10
    v_and_b32 v53, 0xffff0000, v10
    v_lshlrev_b32 v54, 16, v11
    v_and_b32 v55, 0xffff0000, v11
    v_mul_f32_e64 v52, -v52, v48
    v_mul_f32_e64 v53, -v53, v49
    v_mul_f32_e64 v54, -v54, v50
    v_mul_f32_e64 v55, -v55, v51
    v_mul_f32 v48, 0x4b800000, v48
    v_mul_f32 v49, 0x4b800000, v49
    v_mul_f32 v50, 0x4b800000, v50
    v_mul_f32 v51, 0x4b800000, v51
    s_mov_b64 exec, s[76:77]
    v_fma_mix_f32 v32, v16, v48, v52 op_sel:[0,0,0] op_sel_hi:[1,0,0]
    v_fma_mix_f32 v33, v18, v48, v52 op_sel:[0,0,0] op_sel_hi:[1,0,0]
    v_fma_mix_f32 v34, v20, v48, v52 op_sel:[0,0,0] op_sel_hi:[1,0,0]
    v_fma_mix_f32 v35, v22, v48, v52 op_sel:[0,0,0] op_sel_hi:[1,0,0]
    v_fma_mix_f32 v36, v24, v48, v52 op_sel:[0,0,0] op_sel_hi:[1,0,0]
    v_fma_mix_f32 v37, v26, v48, v52 op_sel:[0,0,0] op_sel_hi:[1,0,0]
    v_fma_mix_f32 v38, v28, v48, v52 op_sel:[0,0,0] op_sel_hi:[1,0,0]
    v_fma_mix_f32 v39, v30, v48, v52 op_sel:[0,0,0] op_sel_hi:[1,0,0]
    v_cvt_pk_bf16_f32 v56, v32, v33
    v_cvt_pk_bf16_f32 v57, v34, v35
    v_cvt_pk_bf16_f32 v58, v36, v37
    v_cvt_pk_bf16_f32 v59, v38, v39
    ds_write_b128 v5, v[56:59] offset:0
    v_fma_mix_f32 v32, v16, v49, v53 op_sel:[1,0,0] op_sel_hi:[1,0,0]
    v_fma_mix_f32 v33, v18, v49, v53 op_sel:[1,0,0] op_sel_hi:[1,0,0]
    v_fma_mix_f32 v34, v20, v49, v53 op_sel:[1,0,0] op_sel_hi:[1,0,0]
    v_fma_mix_f32 v35, v22, v49, v53 op_sel:[1,0,0] op_sel_hi:[1,0,0]
    v_fma_mix_f32 v36, v24, v49, v53 op_sel:[1,0,0] op_sel_hi:[1,0,0]
    v_fma_mix_f32 v37, v26, v49, v53 op_sel:[1,0,0] op_sel_hi:[1,0,0]
    v_fma_mix_f32 v38, v28, v49, v53 op_sel:[1,0,0] op_sel_hi:[1,0,0]
    v_fma_mix_f32 v39, v30, v49, v53 op_sel:[1,0,0] op_sel_hi:[1,0,0]
    v_cvt_pk_bf16_f32 v60, v32, v33
    v_cvt_pk_bf16_f32 v61, v34, v35
    v_cvt_pk_bf16_f32 v62, v36, v37
    v_cvt_pk_bf16_f32 v63, v38, v39
    ds_write_b128 v5, v[60:63] offset:16
    v_fma_mix_f32 v32, v17, v50, v54 op_sel:[0,0,0] op_sel_hi:[1,0,0]
    v_fma_mix_f32 v33, v19, v50, v54 op_sel:[0,0,0] op_sel_hi:[1,0,0]
    v_fma_mix_f32 v34, v21, v50, v54 op_sel:[0,0,0] op_sel_hi:[1,0,0]
    v_fma_mix_f32 v35, v23, v50, v54 op_sel:[0,0,0] op_sel_hi:[1,0,0]
    v_fma_mix_f32 v36, v25, v50, v54 op_sel:[0,0,0] op_sel_hi:[1,0,0]
    v_fma_mix_f32 v37, v27, v50, v54 op_sel:[0,0,0] op_sel_hi:[1,0,0]
    v_fma_mix_f32 v38, v29, v50, v54 op_sel:[0,0,0] op_sel_hi:[1,0,0]
    v_fma_mix_f32 v39, v31, v50, v54 op_sel:[0,0,0] op_sel_hi:[1,0,0]
    v_cvt_pk_bf16_f32 v64, v32, v33
    v_cvt_pk_bf16_f32 v65, v34, v35
    v_cvt_pk_bf16_f32 v66, v36, v37
    v_cvt_pk_bf16_f32 v67, v38, v39
    ds_write_b128 v5, v[64:67] offset:32
    v_fma_mix_f32 v32, v17, v51, v55 op_sel:[1,0,0] op_sel_hi:[1,0,0]
    v_fma_mix_f32 v33, v19, v51, v55 op_sel:[1,0,0] op_sel_hi:[1,0,0]
    v_fma_mix_f32 v34, v21, v51, v55 op_sel:[1,0,0] op_sel_hi:[1,0,0]
    v_fma_mix_f32 v35, v23, v51, v55 op_sel:[1,0,0] op_sel_hi:[1,0,0]
    v_fma_mix_f32 v36, v25, v51, v55 op_sel:[1,0,0] op_sel_hi:[1,0,0]
    v_fma_mix_f32 v37, v27, v51, v55 op_sel:[1,0,0] op_sel_hi:[1,0,0]
    v_fma_mix_f32 v38, v29, v51, v55 op_sel:[1,0,0] op_sel_hi:[1,0,0]
    v_fma_mix_f32 v39, v31, v51, v55 op_sel:[1,0,0] op_sel_hi:[1,0,0]
    v_cvt_pk_bf16_f32 v68, v32, v33
    v_cvt_pk_bf16_f32 v69, v34, v35
    v_cvt_pk_bf16_f32 v70, v36, v37
    v_cvt_pk_bf16_f32 v71, v38, v39
    ds_write_b128 v5, v[68:71] offset:48
    s_mov_b64 exec, -1
    s_setpc_b64 s[72:73]
SUB_W:
    s_cmp_lg_u32 s98, 0
    s_cbranch_scc1 L_fallback
    s_bitcmp1_b64 s[80:81], s63
    s_cbranch_scc1 L_rdy
    s_mov_b32 s67, 0
L_poll:
    buffer_load_dwordx2 v[92:93], v12, s[40:43], s64 offen sc1
    s_waitcnt vmcnt(0)
    v_subrev_co_u32 v92, vcc, s96, v92
    s_nop 1
    v_subb_co_u32 v93, vcc, v93, v96, vcc
    v_lshrrev_b32 v92, 20, v92
    v_or_b32 v92, v92, v93
    v_cmp_eq_u32 s[80:81], 0, v92
    s_nop 1
    s_bitcmp1_b64 s[80:81], s63
    s_cbranch_scc1 L_rdy
    s_sleep 2
    s_add_u32 s67, s67, 1
    s_cmp_lt_u32 s67, 48
    s_cbranch_scc1 L_poll
    s_mov_b32 s98, 1
L_fallback:
    s_lshl_b32 s78, s63, 1
    s_add_u32 s68, s62, s60
    v_lshl_add_u32 v5, v2, 6, s68
    s_mov_b32 s79, 0
    s_mov_b64 s[74:75], s[72:73]
L_fb_loop:
    s_mul_i32 s53, s78, 114688
    s_mul_i32 s54, s51, 896
    s_add_u32 s53, s53, s54
    buffer_load_format_d16_xyzw v[16:17], v7, s[20:23], s53 offen nt
    s_add_u32 s53, s53, 14336
    buffer_load_format_d16_xyzw v[18:19], v7, s[20:23], s53 offen nt
    s_add_u32 s53, s53, 14336
    buffer_load_format_d16_xyzw v[20:21], v7, s[20:23], s53 offen nt
    s_add_u32 s53, s53, 14336
    buffer_load_format_d16_xyzw v[22:23], v7, s[20:23], s53 offen nt
    s_add_u32 s53, s53, 14336
    buffer_load_format_d16_xyzw v[24:25], v7, s[20:23], s53 offen nt
    s_add_u32 s53, s53, 14336
    buffer_load_format_d16_xyzw v[26:27], v7, s[20:23], s53 offen nt
    s_add_u32 s53, s53, 14336
    buffer_load_format_d16_xyzw v[28:29], v7, s[20:23], s53 offen nt
    s_add_u32 s53, s53, 14336
    buffer_load_format_d16_xyzw v[30:31], v7, s[20:23], s53 offen nt
    s_lshr_b32 s54, s78, 4
    s_mul_i32 s54, s54, 7168
    s_mul_i32 s55, s51, 448
    s_add_u32 s54, s54, s55
    buffer_load_dwordx2 v[8:9], v4, s[24:27], s54 offen
    buffer_load_dwordx2 v[10:11], v4, s[28:31], s54 offen
    s_waitcnt vmcnt(0)
    s_call_b64 s[72:73], SUB_DEQ
    v_add_u32 v5, 3584, v5
    s_add_u32 s78, s78, 1
    s_add_u32 s79, s79, 1
    s_cmp_lt_u32 s79, 2
    s_cbranch_scc1 L_fb_loop
    s_mov_b64 s[72:73], s[74:75]
    s_waitcnt lgkmcnt(0)
    s_branch L_w_adv
L_rdy:
    s_add_u32 s68, s62, s60
    s_add_u32 m0, s68, 0
    s_add_u32 s67, s57, 0
    buffer_load_dwordx4 v3, s[40:43], s67 offen lds
    s_add_u32 m0, s68, 1024
    s_add_u32 s67, s57, 1024
    buffer_load_dwordx4 v3, s[40:43], s67 offen lds
    s_add_u32 m0, s68, 2048
    s_add_u32 s67, s57, 2048
    buffer_load_dwordx4 v3, s[40:43], s67 offen lds
    s_add_u32 m0, s68, 3072
    s_add_u32 s67, s57, 3072
    buffer_load_dwordx4 v3, s[40:43], s67 offen lds
    s_add_u32 m0, s68, 4096
    s_add_u32 s67, s57, 4096
    buffer_load_dwordx4 v3, s[40:43], s67 offen lds
    s_add_u32 m0, s68, 5120
    s_add_u32 s67, s57, 5120
    buffer_load_dwordx4 v3, s[40:43], s67 offen lds
    s_add_u32 m0, s68, 6144
    s_add_u32 s67, s57, 6144
    buffer_load_dwordx4 v3, s[40:43], s67 offen lds
L_w_adv:
    s_add_u32 s57, s57, 28672
    s_add_u32 s63, s63, 4
    s_cmp_ge_u32 s63, 64
    s_cselect_b32 s57, s101, s57
    s_and_b32 s63, s63, 63
    s_add_u32 s60, s60, 45056
    s_cmp_eq_u32 s60, 135168
    s_cselect_b32 s60, 0, s60
    s_setpc_b64 s[72:73]
SUB_X:
    s_add_u32 s68, s58, s61
    s_add_u32 m0, s68, 0
    s_add_u32 s67, s56, 0
    buffer_load_dwordx4 v14, s[16:19], s67 offen lds
    s_add_u32 m0, s68, 1024
    s_add_u32 s67, s56, 16384
    buffer_load_dwordx4 v15, s[16:19], s67 offen lds
    s_add_u32 m0, s68, 2048
    s_add_u32 s67, s56, 32768
    buffer_load_dwordx4 v14, s[16:19], s67 offen lds
    s_add_u32 m0, s68, 3072
    s_add_u32 s67, s56, 49152
    buffer_load_dwordx4 v15, s[16:19], s67 offen lds
L_x_adv:
    s_add_u32 s56, s56, 128
    s_and_b32 s56, s56, 2047
    s_add_u32 s61, s61, 45056
    s_cmp_eq_u32 s61, 135168
    s_cselect_b32 s61, 0, s61
    s_setpc_b64 s[72:73]
L_helper:
    s_sub_u32 s48, s52, 4
    v_lshrrev_b32 v44, 3, v2
    v_and_b32 v45, 7, v2
    v_lshrrev_b32 v46, 1, v44
    v_xor_b32 v45, v45, v46
    s_lshl_b32 s53, s50, 7
    s_lshl_b32 s54, s48, 5
    s_add_u32 s53, s53, s54
    v_add_u32 v44, s53, v44
    v_lshlrev_b32 v44, 11, v44
    v_lshl_add_u32 v14, v45, 4, v44
    v_xor_b32 v15, 64, v14
    s_lshl_b32 s58, s48, 12
    s_lshl_b32 s56, s100, 7
    s_mov_b32 s61, 0
    s_mul_i32 s101, s51, 458752
    s_mul_i32 s54, s48, 7168
    s_add_u32 s101, s101, s54
    s_mul_i32 s57, s100, 28672
    s_add_u32 s57, s57, s101
    s_add_u32 s62, s54, 16384
    s_mov_b64 s[80:81], 0
    s_mov_b32 s98, 0
    s_lshl_b32 s63, s100, 2
    s_add_u32 s63, s63, s48
    v_mov_b32 v96, s97
    v_lshlrev_b32 v12, 3, v2
    s_lshl_b32 s64, s51, 9
    s_add_u32 s64, s64, 8388608
    s_lshl_b32 s70, s63, 3
    s_add_u32 s70, s70, s64
    v_add_u32 v13, s62, v3
    v_mov_b32 v41, 0
    v_lshlrev_b32 v45, 7, v2
    v_cndmask_b32 v45, v6, v45, s[76:77]
    buffer_load_dword v44, v45, s[40:43], s57 offen nt
    s_waitcnt vmcnt(1)
    s_call_b64 s[72:73], SUB_DEQ
    s_waitcnt lgkmcnt(0)
    s_barrier
    ds_read_b128 v[56:59], v13 offset:0
    ds_read_b128 v[60:63], v13 offset:1024
    ds_read_b128 v[64:67], v13 offset:2048
    ds_read_b128 v[68:71], v13 offset:3072
    ds_read_b128 v[72:75], v13 offset:4096
    ds_read_b128 v[76:79], v13 offset:5120
    ds_read_b128 v[80:83], v13 offset:6144
    s_waitcnt lgkmcnt(6)
    s_add_u32 s67, s57, 0
    buffer_store_dwordx4 v[56:59], v3, s[40:43], s67 offen
    s_waitcnt lgkmcnt(5)
    s_add_u32 s67, s57, 1024
    buffer_store_dwordx4 v[60:63], v3, s[40:43], s67 offen
    s_waitcnt lgkmcnt(4)
    s_add_u32 s67, s57, 2048
    buffer_store_dwordx4 v[64:67], v3, s[40:43], s67 offen
    s_waitcnt lgkmcnt(3)
    s_add_u32 s67, s57, 3072
    buffer_store_dwordx4 v[68:71], v3, s[40:43], s67 offen
    s_waitcnt lgkmcnt(2)
    s_add_u32 s67, s57, 4096
    buffer_store_dwordx4 v[72:75], v3, s[40:43], s67 offen
    s_waitcnt lgkmcnt(1)
    s_add_u32 s67, s57, 5120
    buffer_store_dwordx4 v[76:79], v3, s[40:43], s67 offen
    s_waitcnt lgkmcnt(0)
    s_add_u32 s67, s57, 6144
    buffer_store_dwordx4 v[80:83], v3, s[40:43], s67 offen
    s_barrier
    s_add_u32 s56, s56, 384
    s_and_b32 s56, s56, 2047
    s_waitcnt vmcnt(0)
    s_memrealtime s[74:75]
    s_waitcnt lgkmcnt(0)
    s_and_b32 s75, s75, 0x0fffffff
    s_or_b32 s75, s75, s99
    v_mov_b32 v46, s74
    v_mov_b32 v47, s75
    s_mov_b64 exec, 1
    buffer_store_dwordx2 v[46:47], v41, s[40:43], s70 offen
    s_mov_b64 exec, -1
    s_add_u32 s57, s57, 28672
    s_add_u32 s63, s63, 4
    s_cmp_ge_u32 s63, 64
    s_cselect_b32 s57, s101, s57
    s_and_b32 s63, s63, 63
    s_mov_b32 s60, 45056
    s_barrier
    s_call_b64 s[72:73], SUB_W
    s_call_b64 s[72:73], SUB_W
    s_waitcnt vmcnt(7)
    s_barrier
    s_mov_b32 s59, 3
L_h_loop:
    s_call_b64 s[72:73], SUB_W
    s_call_b64 s[72:73], SUB_X
    s_waitcnt vmcnt(11)
    s_barrier
    s_add_u32 s59, s59, 1
    s_cmp_lt_u32 s59, 16
    s_cbranch_scc1 L_h_loop
    s_waitcnt vmcnt(0)
    s_barrier
    s_mov_b32 s57, 7168
    s_movk_i32 s55, 464
    v_and_b32 v31, 255, v0
    v_add_u32 v32, 0, v31
    v_mul_u32_u24 v33, 9363, v32
    v_lshrrev_b32 v33, 18, v33
    v_mul_u32_u24 v34, 28, v33
    v_sub_u32 v34, v32, v34
    v_lshlrev_b32 v34, 4, v34
    v_and_b32 v35, 32, v33
    v_add_u32 v33, v33, v35
    v_add_u32 v33, 0, v33
    v_mad_u32_u24 v16, v33, s55, v34
    v_mad_u32_u24 v24, v33, s57, v34
    v_add_u32 v32, 256, v31
    v_mul_u32_u24 v33, 9363, v32
    v_lshrrev_b32 v33, 18, v33
    v_mul_u32_u24 v34, 28, v33
    v_sub_u32 v34, v32, v34
    v_lshlrev_b32 v34, 4, v34
    v_and_b32 v35, 32, v33
    v_add_u32 v33, v33, v35
    v_add_u32 v33, 0, v33
    v_mad_u32_u24 v17, v33, s55, v34
    v_mad_u32_u24 v25, v33, s57, v34
    v_add_u32 v32, 512, v31
    v_mul_u32_u24 v33, 9363, v32
    v_lshrrev_b32 v33, 18, v33
    v_mul_u32_u24 v34, 28, v33
    v_sub_u32 v34, v32, v34
    v_lshlrev_b32 v34, 4, v34
    v_and_b32 v35, 32, v33
    v_add_u32 v33, v33, v35
    v_add_u32 v33, 0, v33
    v_mad_u32_u24 v18, v33, s55, v34
    v_mad_u32_u24 v26, v33, s57, v34
    v_add_u32 v32, 768, v31
    v_mul_u32_u24 v33, 9363, v32
    v_lshrrev_b32 v33, 18, v33
    v_mul_u32_u24 v34, 28, v33
    v_sub_u32 v34, v32, v34
    v_lshlrev_b32 v34, 4, v34
    v_and_b32 v35, 32, v33
    v_add_u32 v33, v33, v35
    v_add_u32 v33, 0, v33
    v_mad_u32_u24 v19, v33, s55, v34
    v_mad_u32_u24 v27, v33, s57, v34
    v_add_u32 v32, 1024, v31
    v_mul_u32_u24 v33, 9363, v32
    v_lshrrev_b32 v33, 18, v33
    v_mul_u32_u24 v34, 28, v33
    v_sub_u32 v34, v32, v34
    v_lshlrev_b32 v34, 4, v34
    v_and_b32 v35, 32, v33
    v_add_u32 v33, v33, v35
    v_add_u32 v33, 0, v33
    v_mad_u32_u24 v20, v33, s55, v34
    v_mad_u32_u24 v28, v33, s57, v34
    v_add_u32 v32, 1280, v31
    v_mul_u32_u24 v33, 9363, v32
    v_lshrrev_b32 v33, 18, v33
    v_mul_u32_u24 v34, 28, v33
    v_sub_u32 v34, v32, v34
    v_lshlrev_b32 v34, 4, v34
    v_and_b32 v35, 32, v33
    v_add_u32 v33, v33, v35
    v_add_u32 v33, 0, v33
    v_mad_u32_u24 v21, v33, s55, v34
    v_mad_u32_u24 v29, v33, s57, v34
    v_add_u32 v32, 1536, v31
    v_mul_u32_u24 v33, 9363, v32
    v_lshrrev_b32 v33, 18, v33
    v_mul_u32_u24 v34, 28, v33
    v_sub_u32 v34, v32, v34
    v_lshlrev_b32 v34, 4, v34
    v_and_b32 v35, 32, v33
    v_add_u32 v33, v33, v35
    v_add_u32 v33, 0, v33
    v_mad_u32_u24 v22, v33, s55, v34
    v_mad_u32_u24 v30, v33, s57, v34
    s_barrier
    s_barrier
    s_branch L_store
L_done:
    s_endpgm
.section .rodata,"a"
.p2align 6
.amdhsa_kernel standalone__w4a16_gemm_dequant__prompt_kernel
  .amdhsa_next_free_vgpr 256
  .amdhsa_next_free_sgpr 102
  .amdhsa_accum_offset 256
  .amdhsa_group_segment_fixed_size 0
  .amdhsa_kernarg_size 56
  .amdhsa_user_sgpr_count 2
  .amdhsa_user_sgpr_kernarg_segment_ptr 1
  .amdhsa_system_sgpr_workgroup_id_x 1
.end_amdhsa_kernel
```
